```python
import torch

def _softmax(x, axis=-1):
    return torch.softmax(x, dim=axis)
def _gelu(x):
    return torch.nn.functional.gelu(x, approximate="tanh")
def _silu(x):
    return torch.nn.functional.silu(x)
def _sigmoid(x):
    return torch.sigmoid(x)
def _layernorm(x, axis=-1, eps=1e-5):
    m = x.mean(dim=axis, keepdim=True)
    v = x.var(dim=axis, keepdim=True, unbiased=False)
    return (x - m) / torch.sqrt(v + eps)
def _scatter_add(tgt, idx, src, axis=0):
    return tgt.clone().index_add_(axis, idx, src)
def _segment_sum(src, seg, n):
    out = torch.zeros((n,) + src.shape[1:], dtype=src.dtype)
    return out.index_add_(0, seg, src)
def _pad(x, pw):
    flat = tuple(v for pair in reversed(pw) for v in pair)
    return torch.nn.functional.pad(x, flat)

kernel_name = 'standalone__instancenorm__prompt'

def setup_inputs():

    _w = (lambda a: (lambda t: t.to(torch.bfloat16) if t.is_floating_point() else t)(torch.as_tensor(a)))
    B, C, H, W = 1, 448, 4096, 16
    return {
        "x": _w(abs((lambda *s: torch.randn(*s, dtype=torch.bfloat16) * 0.05)(B, C, H, W))),
        "g": _w((lambda *s: torch.randn(*s, dtype=torch.bfloat16) * 0.05)(C) + 1.0),
        "b": _w((lambda *s: torch.randn(*s, dtype=torch.bfloat16) * 0.4)(C)),
    }

def reference(x, g, b):
    mu = x.mean(axis=(-2, -1), keepdims=True)
    var = ((x - mu) ** 2).mean(axis=(-2, -1), keepdims=True)
    xhat = (x - mu) / torch.sqrt(var + 1e-5)
    return xhat * g.reshape(1, -1, 1, 1) + b.reshape(1, -1, 1, 1)
```

```asm
; @launch grid=(256,1,1) block=(1024,1,1) lds=3840
.amdgcn_target "amdgcn-amd-amdhsa--gfx950"
.text
.globl standalone__instancenorm__prompt_kernel
.p2align 8
.type standalone__instancenorm__prompt_kernel,@function
standalone__instancenorm__prompt_kernel:
    s_cmp_ge_u32 s2, 256
    s_cbranch_scc1 L_end
    s_load_dwordx8 s[44:51], s[0:1], 0
    s_load_dwordx2 s[16:17], s[0:1], 40
    v_lshrrev_b32 v6, 6, v0
    v_and_b32 v7, 63, v0
    v_readfirstlane_b32 s18, v6
    v_lshlrev_b32 v1, 4, v7
    v_mov_b32 v10, 0
    v_lshlrev_b32 v8, 2, v7
    s_lshr_b32 s19, s2, 3
    s_lshl_b32 s19, s19, 1
    s_bfe_u32 s3, s2, 0x10001
    s_or_b32 s19, s19, s3
    s_and_b32 s20, s2, 1
    s_bfe_u32 s21, s2, 0x10002
    s_mov_b32 s6, 0x3800000
    s_mov_b32 s7, 0x20000
    s_lshl_b32 s3, s20, 1
    s_add_u32 s3, s3, s21
    s_lshl_b32 s31, s3, 3
    s_lshl_b32 s54, s3, 15
    s_bfe_u32 s68, s19, 0x20003
    s_lshl_b32 s3, s19, 2
    s_add_u32 s3, s3, s68
    s_lshl_b32 s3, s3, 17
    s_add_u32 s56, s3, s54
    s_lshr_b32 s3, s18, 3
    s_and_b32 s52, s18, 7
    s_lshl_b32 s52, s52, 10
    s_lshl_b32 s3, s3, 14
    s_add_u32 s55, s3, s52
    s_bcnt1_i32_b32 s3, s18
    s_and_b32 s3, s3, 1
    s_cselect_b32 s69, -1, 1
    s_lshl_b32 s3, s3, 13
    s_add_u32 s55, s55, s3
    s_mul_i32 s58, s69, 0x2000
    s_lshl_b32 s36, s2, 8
    s_cmp_lg_u32 s18, 1
    s_cbranch_scc1 L_nozero
    ds_write_b32 v8, v10
L_nozero:
    v_mov_b32 v16, -1
    v_mov_b32 v17, -1
    v_mov_b32 v18, -1
    v_mov_b32 v19, -1
    v_add_u32 v9, s36, v1
    s_cmp_lg_u32 s18, 0
    s_waitcnt lgkmcnt(0)
    s_cbranch_scc1 L_noclear
    s_mov_b64 exec, 0xffff
    global_store_dwordx4 v9, v[16:19], s[16:17] sc0 sc1
    s_mov_b64 exec, -1
L_noclear:
    s_mov_b32 s4, s44
    s_mov_b32 s5, s45
    s_add_u32 s3, s44, 0x800
    s_and_b32 s57, s3, 0x3000
    s_sub_u32 s55, s55, s57
    s_and_b32 s3, s55, 0x7fff
    s_add_u32 s24, s3, s56
    s_add_u32 s3, s58, s55
    s_and_b32 s3, s3, 0x7fff
    s_add_u32 s23, s3, s56
    buffer_load_dwordx4 v[28:31], v1, s[4:7], s24 offen nt
    buffer_load_dwordx4 v[32:35], v1, s[4:7], s23 offen nt
    s_add_u32 s3, s19, 256
    s_lshl_b32 s3, s3, 17
    s_add_u32 s3, s3, s54
    s_lshl_b32 s52, s18, 11
    s_add_u32 s25, s3, s52
    s_add_u32 s26, s25, 0x800000
    s_add_u32 s27, s25, 0x1000000
    s_barrier
    s_mov_b32 s12, s46
    s_mov_b32 s13, s47
    s_mov_b32 s14, s48
    s_mov_b32 s15, s49
    s_mov_b32 s8, s50
    s_mov_b32 s9, s51
    s_mov_b32 s10, 0x3800000
    s_mov_b32 s11, 0x20000
    s_mov_b32 s32, 0x3f803f80
    s_mov_b32 s33, 0xffff0000
    s_mov_b32 s34, 0x00003f80
    s_mov_b32 s35, 0x3f800000
    s_and_b32 s37, s2, -6
    s_lshl_b32 s37, s37, 8
    s_lshr_b32 s3, s18, 2
    s_bfe_u32 s52, s18, 0x10001
    s_lshl_b32 s3, s3, 14
    s_lshl_b32 s52, s52, 12
    s_add_u32 s3, s3, s52
    s_sub_u32 s22, s3, s57
    s_lshl_b32 s70, s20, 16
    s_and_b32 s3, s18, 1
    s_lshl_b32 s3, s3, 11
    s_add_u32 s70, s70, s3
    s_add_u32 s3, s68, 1
    s_and_b32 s3, s3, 3
    s_lshl2_add_u32 s3, s19, s3
    s_lshl_b32 s3, s3, 17
    s_add_u32 s28, s3, s70
    s_add_u32 s3, s68, 2
    s_and_b32 s3, s3, 3
    s_lshl2_add_u32 s3, s19, s3
    s_lshl_b32 s3, s3, 17
    s_add_u32 s29, s3, s70
    s_add_u32 s3, s68, 3
    s_and_b32 s3, s3, 3
    s_lshl2_add_u32 s3, s19, s3
    s_lshl_b32 s3, s3, 17
    s_add_u32 s30, s3, s70
    v_lshrrev_b32 v2, 4, v0
    v_lshlrev_b32 v2, 3, v2
    v_lshlrev_b32 v3, 3, v7
    v_mov_b32 v4, 0
    v_mov_b32 v5, 0
    s_waitcnt vmcnt(1)
    v_dot2c_f32_bf16 v4, s32, v28
    v_dot2c_f32_bf16 v5, v28, v28
    v_dot2c_f32_bf16 v4, s32, v29
    v_dot2c_f32_bf16 v5, v29, v29
    v_dot2c_f32_bf16 v4, s32, v30
    v_dot2c_f32_bf16 v5, v30, v30
    v_dot2c_f32_bf16 v4, s32, v31
    v_dot2c_f32_bf16 v5, v31, v31
    s_getreg_b32 s3, hwreg(HW_REG_IB_STS, 0, 4)
    s_cmp_eq_u32 s3, 1
    s_cselect_b32 s3, s69, 0
    v_mov_b32 v25, s3
    s_waitcnt vmcnt(0)
    buffer_load_dwordx4 v[36:39], v1, s[4:7], s25 offen nt
    buffer_load_dwordx4 v[40:43], v1, s[4:7], s25 offen offset:1024 nt
    v_dot2c_f32_bf16 v4, s32, v32
    v_dot2c_f32_bf16 v5, v32, v32
    v_dot2c_f32_bf16 v4, s32, v33
    v_dot2c_f32_bf16 v5, v33, v33
    v_dot2c_f32_bf16 v4, s32, v34
    v_dot2c_f32_bf16 v5, v34, v34
    v_dot2c_f32_bf16 v4, s32, v35
    v_dot2c_f32_bf16 v5, v35, v35
    s_nop 2
    v_mul_f32 v8, 0x3d800000, v4
    v_mov_b32_dpp v9, v4 row_newbcast:0 row_mask:0xf bank_mask:0xf
    v_fma_f32 v7, -v4, v8, v5
    v_add_f32_dpp v6, v4, v4 quad_perm:[1,0,3,2] row_mask:0xf bank_mask:0xf
    v_sub_f32 v24, v4, v9
    v_mul_f32 v8, 0x3d800000, v24
    v_add_f32_dpp v6, v6, v6 quad_perm:[2,3,0,1] row_mask:0xf bank_mask:0xf
    v_fmac_f32 v7, v24, v8
    v_mov_b32 v4, 0
    v_add_f32_dpp v6, v6, v6 row_half_mirror row_mask:0xf bank_mask:0xf
    v_add_f32_dpp v7, v7, v7 quad_perm:[1,0,3,2] row_mask:0xf bank_mask:0xf
    v_mov_b32 v5, 0
    v_add_f32_dpp v6, v6, v6 row_mirror row_mask:0xf bank_mask:0xf
    v_add_f32_dpp v7, v7, v7 quad_perm:[2,3,0,1] row_mask:0xf bank_mask:0xf
    v_mul_f32 v9, 0x41800000, v9
    v_sub_f32 v24, v6, v9
    v_add_f32_dpp v7, v7, v7 row_half_mirror row_mask:0xf bank_mask:0xf
    v_mul_f32 v8, 0x3b800000, v24
    s_nop 0
    v_add_f32_dpp v7, v7, v7 row_mirror row_mask:0xf bank_mask:0xf
    v_fma_f32 v7, -v24, v8, v7
    s_mov_b32 exec_lo, 0x00010001
    s_mov_b32 exec_hi, 0x00010001
    ds_write_b64 v2, v[6:7] offset:256
    s_mov_b64 exec, 1
    ds_add_u32 v10, v25 offset:32
    s_mov_b64 exec, -1
    s_waitcnt lgkmcnt(0)
    s_barrier
    s_cmp_lg_u32 s18, 0
    s_cbranch_scc1 L_t1
    s_mov_b32 s38, 0
    s_mov_b32 s39, s31
    s_call_b64 s[40:41], L_pub
L_t1:
    s_waitcnt vmcnt(0)
    buffer_load_dwordx4 v[44:47], v1, s[4:7], s26 offen nt
    buffer_load_dwordx4 v[48:51], v1, s[4:7], s26 offen offset:1024 nt
    v_dot2c_f32_bf16 v4, s32, v36
    v_dot2c_f32_bf16 v5, v36, v36
    v_dot2c_f32_bf16 v4, s32, v37
    v_dot2c_f32_bf16 v5, v37, v37
    v_dot2c_f32_bf16 v4, s32, v38
    v_dot2c_f32_bf16 v5, v38, v38
    v_dot2c_f32_bf16 v4, s32, v39
    v_dot2c_f32_bf16 v5, v39, v39
    v_dot2c_f32_bf16 v4, s32, v40
    v_dot2c_f32_bf16 v5, v40, v40
    v_dot2c_f32_bf16 v4, s32, v41
    v_dot2c_f32_bf16 v5, v41, v41
    v_dot2c_f32_bf16 v4, s32, v42
    v_dot2c_f32_bf16 v5, v42, v42
    v_dot2c_f32_bf16 v4, s32, v43
    v_dot2c_f32_bf16 v5, v43, v43
    s_nop 2
    v_mul_f32 v8, 0x3d800000, v4
    v_mov_b32_dpp v9, v4 row_newbcast:0 row_mask:0xf bank_mask:0xf
    v_fma_f32 v7, -v4, v8, v5
    v_add_f32_dpp v6, v4, v4 quad_perm:[1,0,3,2] row_mask:0xf bank_mask:0xf
    v_sub_f32 v24, v4, v9
    v_mul_f32 v8, 0x3d800000, v24
    v_add_f32_dpp v6, v6, v6 quad_perm:[2,3,0,1] row_mask:0xf bank_mask:0xf
    v_fmac_f32 v7, v24, v8
    v_mov_b32 v4, 0
    v_add_f32_dpp v6, v6, v6 row_half_mirror row_mask:0xf bank_mask:0xf
    v_add_f32_dpp v7, v7, v7 quad_perm:[1,0,3,2] row_mask:0xf bank_mask:0xf
    v_mov_b32 v5, 0
    v_add_f32_dpp v6, v6, v6 row_mirror row_mask:0xf bank_mask:0xf
    v_add_f32_dpp v7, v7, v7 quad_perm:[2,3,0,1] row_mask:0xf bank_mask:0xf
    v_mul_f32 v9, 0x41800000, v9
    v_sub_f32 v24, v6, v9
    v_add_f32_dpp v7, v7, v7 row_half_mirror row_mask:0xf bank_mask:0xf
    v_mul_f32 v8, 0x3b800000, v24
    s_nop 0
    v_add_f32_dpp v7, v7, v7 row_mirror row_mask:0xf bank_mask:0xf
    v_fma_f32 v7, -v24, v8, v7
    s_mov_b32 exec_lo, 0x00010001
    s_mov_b32 exec_hi, 0x00010001
    ds_write_b64 v2, v[6:7] offset:768
    s_mov_b64 exec, -1
    s_waitcnt lgkmcnt(0)
    s_barrier
    s_cmp_lg_u32 s18, 0
    s_cbranch_scc1 L_t2
    s_mov_b32 s38, 1
    s_mov_b32 s39, s31
    s_call_b64 s[40:41], L_pub
L_t2:
    s_waitcnt vmcnt(0)
    buffer_load_dwordx4 v[52:55], v1, s[4:7], s27 offen nt
    buffer_load_dwordx4 v[56:59], v1, s[4:7], s27 offen offset:1024 nt
    v_dot2c_f32_bf16 v4, s32, v44
    v_dot2c_f32_bf16 v5, v44, v44
    v_dot2c_f32_bf16 v4, s32, v45
    v_dot2c_f32_bf16 v5, v45, v45
    v_dot2c_f32_bf16 v4, s32, v46
    v_dot2c_f32_bf16 v5, v46, v46
    v_dot2c_f32_bf16 v4, s32, v47
    v_dot2c_f32_bf16 v5, v47, v47
    v_dot2c_f32_bf16 v4, s32, v48
    v_dot2c_f32_bf16 v5, v48, v48
    v_dot2c_f32_bf16 v4, s32, v49
    v_dot2c_f32_bf16 v5, v49, v49
    v_dot2c_f32_bf16 v4, s32, v50
    v_dot2c_f32_bf16 v5, v50, v50
    v_dot2c_f32_bf16 v4, s32, v51
    v_dot2c_f32_bf16 v5, v51, v51
    s_nop 2
    v_mul_f32 v8, 0x3d800000, v4
    v_mov_b32_dpp v9, v4 row_newbcast:0 row_mask:0xf bank_mask:0xf
    v_fma_f32 v7, -v4, v8, v5
    v_add_f32_dpp v6, v4, v4 quad_perm:[1,0,3,2] row_mask:0xf bank_mask:0xf
    v_sub_f32 v24, v4, v9
    v_mul_f32 v8, 0x3d800000, v24
    v_add_f32_dpp v6, v6, v6 quad_perm:[2,3,0,1] row_mask:0xf bank_mask:0xf
    v_fmac_f32 v7, v24, v8
    v_mov_b32 v4, 0
    v_add_f32_dpp v6, v6, v6 row_half_mirror row_mask:0xf bank_mask:0xf
    v_add_f32_dpp v7, v7, v7 quad_perm:[1,0,3,2] row_mask:0xf bank_mask:0xf
    v_mov_b32 v5, 0
    v_add_f32_dpp v6, v6, v6 row_mirror row_mask:0xf bank_mask:0xf
    v_add_f32_dpp v7, v7, v7 quad_perm:[2,3,0,1] row_mask:0xf bank_mask:0xf
    v_mul_f32 v9, 0x41800000, v9
    v_sub_f32 v24, v6, v9
    v_add_f32_dpp v7, v7, v7 row_half_mirror row_mask:0xf bank_mask:0xf
    v_mul_f32 v8, 0x3b800000, v24
    s_nop 0
    v_add_f32_dpp v7, v7, v7 row_mirror row_mask:0xf bank_mask:0xf
    v_fma_f32 v7, -v24, v8, v7
    s_mov_b32 exec_lo, 0x00010001
    s_mov_b32 exec_hi, 0x00010001
    ds_write_b64 v2, v[6:7] offset:1280
    s_mov_b64 exec, -1
    s_cmp_lg_u32 s18, 1
    s_cbranch_scc1 L_t3
    s_mov_b32 s38, 0
    s_mov_b32 s39, s24
    s_call_b64 s[40:41], L_poll
L_t3:
    s_waitcnt lgkmcnt(0)
    s_barrier
    ds_read_b128 v[12:15], v10 offset:64
    s_cmp_lg_u32 s18, 0
    s_cbranch_scc1 L_t4
    s_mov_b32 s38, 2
    s_mov_b32 s39, s31
    s_call_b64 s[40:41], L_pub
    s_branch L_u4
L_t4:
    s_waitcnt lgkmcnt(0)
L_u4:
L_chk5:
    v_cmp_eq_u32 vcc, 0, v15
    s_cbranch_vccz L_rdy5
    s_sleep 1
    ds_read_b128 v[12:15], v10 offset:64
    s_waitcnt lgkmcnt(0)
    s_branch L_chk5
L_rdy5:
    v_cmp_eq_u32 vcc, 2, v15
    s_mov_b32 s38, 0
    s_cbranch_vccnz L_fallback
    v_readfirstlane_b32 s3, v15
    s_nop 0
    s_bfe_u32 s3, s3, 0x10002
    s_lshl_b32 s64, s3, 13
    s_add_u32 s64, s64, s22
    s_and_b32 s64, s64, 0xffff
    s_add_u32 s28, s28, s64
    s_add_u32 s29, s29, s64
    s_add_u32 s30, s30, s64
    s_lshl1_add_u32 s3, s20, s3
    s_lshl_b32 s42, s3, 3
    v_dot2_f32_bf16 v16, v28, s34, v14
    v_dot2_f32_bf16 v17, v28, s35, v14
    v_dot2_f32_bf16 v18, v29, s34, v14
    v_dot2_f32_bf16 v19, v29, s35, v14
    v_dot2_f32_bf16 v20, v30, s34, v14
    v_dot2_f32_bf16 v21, v30, s35, v14
    v_dot2_f32_bf16 v22, v31, s34, v14
    v_dot2_f32_bf16 v23, v31, s35, v14
    v_pk_fma_f32 v[16:17], v[16:17], v[12:13], v[12:13] op_sel:[0,0,1] op_sel_hi:[1,0,1]
    v_pk_fma_f32 v[18:19], v[18:19], v[12:13], v[12:13] op_sel:[0,0,1] op_sel_hi:[1,0,1]
    v_pk_fma_f32 v[20:21], v[20:21], v[12:13], v[12:13] op_sel:[0,0,1] op_sel_hi:[1,0,1]
    v_pk_fma_f32 v[22:23], v[22:23], v[12:13], v[12:13] op_sel:[0,0,1] op_sel_hi:[1,0,1]
    v_cvt_pk_bf16_f32 v28, v16, v17
    v_cvt_pk_bf16_f32 v29, v18, v19
    v_cvt_pk_bf16_f32 v30, v20, v21
    v_cvt_pk_bf16_f32 v31, v22, v23
    buffer_store_dwordx4 v[28:31], v1, s[8:11], s24 offen sc1
    v_dot2_f32_bf16 v16, v32, s34, v14
    v_dot2_f32_bf16 v17, v32, s35, v14
    v_dot2_f32_bf16 v18, v33, s34, v14
    v_dot2_f32_bf16 v19, v33, s35, v14
    v_dot2_f32_bf16 v20, v34, s34, v14
    v_dot2_f32_bf16 v21, v34, s35, v14
    v_dot2_f32_bf16 v22, v35, s34, v14
    v_dot2_f32_bf16 v23, v35, s35, v14
    v_pk_fma_f32 v[16:17], v[16:17], v[12:13], v[12:13] op_sel:[0,0,1] op_sel_hi:[1,0,1]
    v_pk_fma_f32 v[18:19], v[18:19], v[12:13], v[12:13] op_sel:[0,0,1] op_sel_hi:[1,0,1]
    v_pk_fma_f32 v[20:21], v[20:21], v[12:13], v[12:13] op_sel:[0,0,1] op_sel_hi:[1,0,1]
    v_pk_fma_f32 v[22:23], v[22:23], v[12:13], v[12:13] op_sel:[0,0,1] op_sel_hi:[1,0,1]
    v_cvt_pk_bf16_f32 v32, v16, v17
    v_cvt_pk_bf16_f32 v33, v18, v19
    v_cvt_pk_bf16_f32 v34, v20, v21
    v_cvt_pk_bf16_f32 v35, v22, v23
    buffer_store_dwordx4 v[32:35], v1, s[8:11], s23 offen sc1
    s_waitcnt vmcnt(2)
    buffer_load_dwordx4 v[60:63], v1, s[4:7], s28 offen nt
    buffer_load_dwordx4 v[64:67], v1, s[4:7], s28 offen offset:1024 nt
    v_dot2c_f32_bf16 v4, s32, v52
    v_dot2c_f32_bf16 v5, v52, v52
    v_dot2c_f32_bf16 v4, s32, v53
    v_dot2c_f32_bf16 v5, v53, v53
    v_dot2c_f32_bf16 v4, s32, v54
    v_dot2c_f32_bf16 v5, v54, v54
    v_dot2c_f32_bf16 v4, s32, v55
    v_dot2c_f32_bf16 v5, v55, v55
    v_dot2c_f32_bf16 v4, s32, v56
    v_dot2c_f32_bf16 v5, v56, v56
    v_dot2c_f32_bf16 v4, s32, v57
    v_dot2c_f32_bf16 v5, v57, v57
    v_dot2c_f32_bf16 v4, s32, v58
    v_dot2c_f32_bf16 v5, v58, v58
    v_dot2c_f32_bf16 v4, s32, v59
    v_dot2c_f32_bf16 v5, v59, v59
    s_nop 2
    v_mul_f32 v8, 0x3d800000, v4
    v_mov_b32_dpp v9, v4 row_newbcast:0 row_mask:0xf bank_mask:0xf
    v_fma_f32 v7, -v4, v8, v5
    v_add_f32_dpp v6, v4, v4 quad_perm:[1,0,3,2] row_mask:0xf bank_mask:0xf
    v_sub_f32 v24, v4, v9
    v_mul_f32 v8, 0x3d800000, v24
    v_add_f32_dpp v6, v6, v6 quad_perm:[2,3,0,1] row_mask:0xf bank_mask:0xf
    v_fmac_f32 v7, v24, v8
    v_mov_b32 v4, 0
    v_add_f32_dpp v6, v6, v6 row_half_mirror row_mask:0xf bank_mask:0xf
    v_add_f32_dpp v7, v7, v7 quad_perm:[1,0,3,2] row_mask:0xf bank_mask:0xf
    v_mov_b32 v5, 0
    v_add_f32_dpp v6, v6, v6 row_mirror row_mask:0xf bank_mask:0xf
    v_add_f32_dpp v7, v7, v7 quad_perm:[2,3,0,1] row_mask:0xf bank_mask:0xf
    v_mul_f32 v9, 0x41800000, v9
    v_sub_f32 v24, v6, v9
    v_add_f32_dpp v7, v7, v7 row_half_mirror row_mask:0xf bank_mask:0xf
    v_mul_f32 v8, 0x3b800000, v24
    s_nop 0
    v_add_f32_dpp v7, v7, v7 row_mirror row_mask:0xf bank_mask:0xf
    v_fma_f32 v7, -v24, v8, v7
    s_mov_b32 exec_lo, 0x00010001
    s_mov_b32 exec_hi, 0x00010001
    ds_write_b64 v2, v[6:7] offset:1792
    s_mov_b64 exec, -1
    s_cmp_lg_u32 s18, 1
    s_cbranch_scc1 L_t6
    s_mov_b32 s38, 1
    s_mov_b32 s39, s25
    s_call_b64 s[40:41], L_poll
L_t6:
    s_waitcnt lgkmcnt(0)
    s_barrier
    ds_read_b128 v[12:15], v10 offset:80
    s_cmp_lg_u32 s18, 0
    s_cbranch_scc1 L_t7
    s_mov_b32 s38, 3
    s_mov_b32 s39, s31
    s_call_b64 s[40:41], L_pub
    s_branch L_u7
L_t7:
    s_waitcnt lgkmcnt(0)
L_u7:
L_chk8:
    v_cmp_eq_u32 vcc, 0, v15
    s_cbranch_vccz L_rdy8
    s_sleep 1
    ds_read_b128 v[12:15], v10 offset:80
    s_waitcnt lgkmcnt(0)
    s_branch L_chk8
L_rdy8:
    v_cmp_eq_u32 vcc, 2, v15
    s_mov_b32 s38, 1
    s_cbranch_vccnz L_fallback
    v_dot2_f32_bf16 v16, v36, s34, v14
    v_dot2_f32_bf16 v17, v36, s35, v14
    v_dot2_f32_bf16 v18, v37, s34, v14
    v_dot2_f32_bf16 v19, v37, s35, v14
    v_dot2_f32_bf16 v20, v38, s34, v14
    v_dot2_f32_bf16 v21, v38, s35, v14
    v_dot2_f32_bf16 v22, v39, s34, v14
    v_dot2_f32_bf16 v23, v39, s35, v14
    v_pk_fma_f32 v[16:17], v[16:17], v[12:13], v[12:13] op_sel:[0,0,1] op_sel_hi:[1,0,1]
    v_pk_fma_f32 v[18:19], v[18:19], v[12:13], v[12:13] op_sel:[0,0,1] op_sel_hi:[1,0,1]
    v_pk_fma_f32 v[20:21], v[20:21], v[12:13], v[12:13] op_sel:[0,0,1] op_sel_hi:[1,0,1]
    v_pk_fma_f32 v[22:23], v[22:23], v[12:13], v[12:13] op_sel:[0,0,1] op_sel_hi:[1,0,1]
    v_cvt_pk_bf16_f32 v36, v16, v17
    v_cvt_pk_bf16_f32 v37, v18, v19
    v_cvt_pk_bf16_f32 v38, v20, v21
    v_cvt_pk_bf16_f32 v39, v22, v23
    buffer_store_dwordx4 v[36:39], v1, s[8:11], s25 offen sc1
    v_dot2_f32_bf16 v16, v40, s34, v14
    v_dot2_f32_bf16 v17, v40, s35, v14
    v_dot2_f32_bf16 v18, v41, s34, v14
    v_dot2_f32_bf16 v19, v41, s35, v14
    v_dot2_f32_bf16 v20, v42, s34, v14
    v_dot2_f32_bf16 v21, v42, s35, v14
    v_dot2_f32_bf16 v22, v43, s34, v14
    v_dot2_f32_bf16 v23, v43, s35, v14
    v_pk_fma_f32 v[16:17], v[16:17], v[12:13], v[12:13] op_sel:[0,0,1] op_sel_hi:[1,0,1]
    v_pk_fma_f32 v[18:19], v[18:19], v[12:13], v[12:13] op_sel:[0,0,1] op_sel_hi:[1,0,1]
    v_pk_fma_f32 v[20:21], v[20:21], v[12:13], v[12:13] op_sel:[0,0,1] op_sel_hi:[1,0,1]
    v_pk_fma_f32 v[22:23], v[22:23], v[12:13], v[12:13] op_sel:[0,0,1] op_sel_hi:[1,0,1]
    v_cvt_pk_bf16_f32 v40, v16, v17
    v_cvt_pk_bf16_f32 v41, v18, v19
    v_cvt_pk_bf16_f32 v42, v20, v21
    v_cvt_pk_bf16_f32 v43, v22, v23
    buffer_store_dwordx4 v[40:43], v1, s[8:11], s25 offen offset:1024 sc1
    s_waitcnt vmcnt(2)
    buffer_load_dwordx4 v[68:71], v1, s[4:7], s29 offen nt
    buffer_load_dwordx4 v[72:75], v1, s[4:7], s29 offen offset:1024 nt
    v_dot2c_f32_bf16 v4, s32, v60
    v_dot2c_f32_bf16 v5, v60, v60
    v_dot2c_f32_bf16 v4, s32, v61
    v_dot2c_f32_bf16 v5, v61, v61
    v_dot2c_f32_bf16 v4, s32, v62
    v_dot2c_f32_bf16 v5, v62, v62
    v_dot2c_f32_bf16 v4, s32, v63
    v_dot2c_f32_bf16 v5, v63, v63
    v_dot2c_f32_bf16 v4, s32, v64
    v_dot2c_f32_bf16 v5, v64, v64
    v_dot2c_f32_bf16 v4, s32, v65
    v_dot2c_f32_bf16 v5, v65, v65
    v_dot2c_f32_bf16 v4, s32, v66
    v_dot2c_f32_bf16 v5, v66, v66
    v_dot2c_f32_bf16 v4, s32, v67
    v_dot2c_f32_bf16 v5, v67, v67
    s_nop 2
    v_mul_f32 v8, 0x3d800000, v4
    v_mov_b32_dpp v9, v4 row_newbcast:0 row_mask:0xf bank_mask:0xf
    v_fma_f32 v7, -v4, v8, v5
    v_add_f32_dpp v6, v4, v4 quad_perm:[1,0,3,2] row_mask:0xf bank_mask:0xf
    v_sub_f32 v24, v4, v9
    v_mul_f32 v8, 0x3d800000, v24
    v_add_f32_dpp v6, v6, v6 quad_perm:[2,3,0,1] row_mask:0xf bank_mask:0xf
    v_fmac_f32 v7, v24, v8
    v_mov_b32 v4, 0
    v_add_f32_dpp v6, v6, v6 row_half_mirror row_mask:0xf bank_mask:0xf
    v_add_f32_dpp v7, v7, v7 quad_perm:[1,0,3,2] row_mask:0xf bank_mask:0xf
    v_mov_b32 v5, 0
    v_add_f32_dpp v6, v6, v6 row_mirror row_mask:0xf bank_mask:0xf
    v_add_f32_dpp v7, v7, v7 quad_perm:[2,3,0,1] row_mask:0xf bank_mask:0xf
    v_mul_f32 v9, 0x41800000, v9
    v_sub_f32 v24, v6, v9
    v_add_f32_dpp v7, v7, v7 row_half_mirror row_mask:0xf bank_mask:0xf
    v_mul_f32 v8, 0x3b800000, v24
    s_nop 0
    v_add_f32_dpp v7, v7, v7 row_mirror row_mask:0xf bank_mask:0xf
    v_fma_f32 v7, -v24, v8, v7
    s_mov_b32 exec_lo, 0x00010001
    s_mov_b32 exec_hi, 0x00010001
    ds_write_b64 v2, v[6:7] offset:2304
    s_mov_b64 exec, -1
    s_cmp_lg_u32 s18, 1
    s_cbranch_scc1 L_t9
    s_mov_b32 s38, 2
    s_mov_b32 s39, s26
    s_call_b64 s[40:41], L_poll
L_t9:
    s_waitcnt lgkmcnt(0)
    s_barrier
    ds_read_b128 v[12:15], v10 offset:96
    s_cmp_lg_u32 s18, 0
    s_cbranch_scc1 L_t10
    s_mov_b32 s38, 4
    s_mov_b32 s39, s42
    s_call_b64 s[40:41], L_pub
    s_branch L_u10
L_t10:
    s_waitcnt lgkmcnt(0)
L_u10:
L_chk11:
    v_cmp_eq_u32 vcc, 0, v15
    s_cbranch_vccz L_rdy11
    s_sleep 1
    ds_read_b128 v[12:15], v10 offset:96
    s_waitcnt lgkmcnt(0)
    s_branch L_chk11
L_rdy11:
    v_cmp_eq_u32 vcc, 2, v15
    s_mov_b32 s38, 2
    s_cbranch_vccnz L_fallback
    v_dot2_f32_bf16 v16, v44, s34, v14
    v_dot2_f32_bf16 v17, v44, s35, v14
    v_dot2_f32_bf16 v18, v45, s34, v14
    v_dot2_f32_bf16 v19, v45, s35, v14
    v_dot2_f32_bf16 v20, v46, s34, v14
    v_dot2_f32_bf16 v21, v46, s35, v14
    v_dot2_f32_bf16 v22, v47, s34, v14
    v_dot2_f32_bf16 v23, v47, s35, v14
    v_pk_fma_f32 v[16:17], v[16:17], v[12:13], v[12:13] op_sel:[0,0,1] op_sel_hi:[1,0,1]
    v_pk_fma_f32 v[18:19], v[18:19], v[12:13], v[12:13] op_sel:[0,0,1] op_sel_hi:[1,0,1]
    v_pk_fma_f32 v[20:21], v[20:21], v[12:13], v[12:13] op_sel:[0,0,1] op_sel_hi:[1,0,1]
    v_pk_fma_f32 v[22:23], v[22:23], v[12:13], v[12:13] op_sel:[0,0,1] op_sel_hi:[1,0,1]
    v_cvt_pk_bf16_f32 v44, v16, v17
    v_cvt_pk_bf16_f32 v45, v18, v19
    v_cvt_pk_bf16_f32 v46, v20, v21
    v_cvt_pk_bf16_f32 v47, v22, v23
    buffer_store_dwordx4 v[44:47], v1, s[8:11], s26 offen sc1
    v_dot2_f32_bf16 v16, v48, s34, v14
    v_dot2_f32_bf16 v17, v48, s35, v14
    v_dot2_f32_bf16 v18, v49, s34, v14
    v_dot2_f32_bf16 v19, v49, s35, v14
    v_dot2_f32_bf16 v20, v50, s34, v14
    v_dot2_f32_bf16 v21, v50, s35, v14
    v_dot2_f32_bf16 v22, v51, s34, v14
    v_dot2_f32_bf16 v23, v51, s35, v14
    v_pk_fma_f32 v[16:17], v[16:17], v[12:13], v[12:13] op_sel:[0,0,1] op_sel_hi:[1,0,1]
    v_pk_fma_f32 v[18:19], v[18:19], v[12:13], v[12:13] op_sel:[0,0,1] op_sel_hi:[1,0,1]
    v_pk_fma_f32 v[20:21], v[20:21], v[12:13], v[12:13] op_sel:[0,0,1] op_sel_hi:[1,0,1]
    v_pk_fma_f32 v[22:23], v[22:23], v[12:13], v[12:13] op_sel:[0,0,1] op_sel_hi:[1,0,1]
    v_cvt_pk_bf16_f32 v48, v16, v17
    v_cvt_pk_bf16_f32 v49, v18, v19
    v_cvt_pk_bf16_f32 v50, v20, v21
    v_cvt_pk_bf16_f32 v51, v22, v23
    buffer_store_dwordx4 v[48:51], v1, s[8:11], s26 offen offset:1024 sc1
    s_waitcnt vmcnt(2)
    buffer_load_dwordx4 v[76:79], v1, s[4:7], s30 offen nt
    buffer_load_dwordx4 v[80:83], v1, s[4:7], s30 offen offset:1024 nt
    v_dot2c_f32_bf16 v4, s32, v68
    v_dot2c_f32_bf16 v5, v68, v68
    v_dot2c_f32_bf16 v4, s32, v69
    v_dot2c_f32_bf16 v5, v69, v69
    v_dot2c_f32_bf16 v4, s32, v70
    v_dot2c_f32_bf16 v5, v70, v70
    v_dot2c_f32_bf16 v4, s32, v71
    v_dot2c_f32_bf16 v5, v71, v71
    v_dot2c_f32_bf16 v4, s32, v72
    v_dot2c_f32_bf16 v5, v72, v72
    v_dot2c_f32_bf16 v4, s32, v73
    v_dot2c_f32_bf16 v5, v73, v73
    v_dot2c_f32_bf16 v4, s32, v74
    v_dot2c_f32_bf16 v5, v74, v74
    v_dot2c_f32_bf16 v4, s32, v75
    v_dot2c_f32_bf16 v5, v75, v75
    s_nop 2
    v_mul_f32 v8, 0x3d800000, v4
    v_mov_b32_dpp v9, v4 row_newbcast:0 row_mask:0xf bank_mask:0xf
    v_fma_f32 v7, -v4, v8, v5
    v_add_f32_dpp v6, v4, v4 quad_perm:[1,0,3,2] row_mask:0xf bank_mask:0xf
    v_sub_f32 v24, v4, v9
    v_mul_f32 v8, 0x3d800000, v24
    v_add_f32_dpp v6, v6, v6 quad_perm:[2,3,0,1] row_mask:0xf bank_mask:0xf
    v_fmac_f32 v7, v24, v8
    v_mov_b32 v4, 0
    v_add_f32_dpp v6, v6, v6 row_half_mirror row_mask:0xf bank_mask:0xf
    v_add_f32_dpp v7, v7, v7 quad_perm:[1,0,3,2] row_mask:0xf bank_mask:0xf
    v_mov_b32 v5, 0
    v_add_f32_dpp v6, v6, v6 row_mirror row_mask:0xf bank_mask:0xf
    v_add_f32_dpp v7, v7, v7 quad_perm:[2,3,0,1] row_mask:0xf bank_mask:0xf
    v_mul_f32 v9, 0x41800000, v9
    v_sub_f32 v24, v6, v9
    v_add_f32_dpp v7, v7, v7 row_half_mirror row_mask:0xf bank_mask:0xf
    v_mul_f32 v8, 0x3b800000, v24
    s_nop 0
    v_add_f32_dpp v7, v7, v7 row_mirror row_mask:0xf bank_mask:0xf
    v_fma_f32 v7, -v24, v8, v7
    s_mov_b32 exec_lo, 0x00010001
    s_mov_b32 exec_hi, 0x00010001
    ds_write_b64 v2, v[6:7] offset:2816
    s_mov_b64 exec, -1
    s_cmp_lg_u32 s18, 1
    s_cbranch_scc1 L_t12
    s_mov_b32 s38, 3
    s_mov_b32 s39, s27
    s_call_b64 s[40:41], L_poll
L_t12:
    s_waitcnt lgkmcnt(0)
    s_barrier
    ds_read_b128 v[12:15], v10 offset:112
    s_cmp_lg_u32 s18, 0
    s_cbranch_scc1 L_t13
    s_mov_b32 s38, 5
    s_mov_b32 s39, s42
    s_call_b64 s[40:41], L_pub
    s_branch L_u13
L_t13:
    s_waitcnt lgkmcnt(0)
L_u13:
    s_cmp_lg_u32 s18, 2
    s_cbranch_scc1 L_t14
    s_mov_b32 s38, 4
    s_mov_b32 s39, s28
    s_call_b64 s[40:41], L_poll
L_t14:
L_chk15:
    v_cmp_eq_u32 vcc, 0, v15
    s_cbranch_vccz L_rdy15
    s_sleep 1
    ds_read_b128 v[12:15], v10 offset:112
    s_waitcnt lgkmcnt(0)
    s_branch L_chk15
L_rdy15:
    v_cmp_eq_u32 vcc, 2, v15
    s_mov_b32 s38, 3
    s_cbranch_vccnz L_fallback
    v_dot2_f32_bf16 v16, v52, s34, v14
    v_dot2_f32_bf16 v17, v52, s35, v14
    v_dot2_f32_bf16 v18, v53, s34, v14
    v_dot2_f32_bf16 v19, v53, s35, v14
    v_dot2_f32_bf16 v20, v54, s34, v14
    v_dot2_f32_bf16 v21, v54, s35, v14
    v_dot2_f32_bf16 v22, v55, s34, v14
    v_dot2_f32_bf16 v23, v55, s35, v14
    v_pk_fma_f32 v[16:17], v[16:17], v[12:13], v[12:13] op_sel:[0,0,1] op_sel_hi:[1,0,1]
    v_pk_fma_f32 v[18:19], v[18:19], v[12:13], v[12:13] op_sel:[0,0,1] op_sel_hi:[1,0,1]
    v_pk_fma_f32 v[20:21], v[20:21], v[12:13], v[12:13] op_sel:[0,0,1] op_sel_hi:[1,0,1]
    v_pk_fma_f32 v[22:23], v[22:23], v[12:13], v[12:13] op_sel:[0,0,1] op_sel_hi:[1,0,1]
    v_cvt_pk_bf16_f32 v52, v16, v17
    v_cvt_pk_bf16_f32 v53, v18, v19
    v_cvt_pk_bf16_f32 v54, v20, v21
    v_cvt_pk_bf16_f32 v55, v22, v23
    buffer_store_dwordx4 v[52:55], v1, s[8:11], s27 offen sc1
    v_dot2_f32_bf16 v16, v56, s34, v14
    v_dot2_f32_bf16 v17, v56, s35, v14
    v_dot2_f32_bf16 v18, v57, s34, v14
    v_dot2_f32_bf16 v19, v57, s35, v14
    v_dot2_f32_bf16 v20, v58, s34, v14
    v_dot2_f32_bf16 v21, v58, s35, v14
    v_dot2_f32_bf16 v22, v59, s34, v14
    v_dot2_f32_bf16 v23, v59, s35, v14
    v_pk_fma_f32 v[16:17], v[16:17], v[12:13], v[12:13] op_sel:[0,0,1] op_sel_hi:[1,0,1]
    v_pk_fma_f32 v[18:19], v[18:19], v[12:13], v[12:13] op_sel:[0,0,1] op_sel_hi:[1,0,1]
    v_pk_fma_f32 v[20:21], v[20:21], v[12:13], v[12:13] op_sel:[0,0,1] op_sel_hi:[1,0,1]
    v_pk_fma_f32 v[22:23], v[22:23], v[12:13], v[12:13] op_sel:[0,0,1] op_sel_hi:[1,0,1]
    v_cvt_pk_bf16_f32 v56, v16, v17
    v_cvt_pk_bf16_f32 v57, v18, v19
    v_cvt_pk_bf16_f32 v58, v20, v21
    v_cvt_pk_bf16_f32 v59, v22, v23
    buffer_store_dwordx4 v[56:59], v1, s[8:11], s27 offen offset:1024 sc1
    s_cmp_lg_u32 s18, 1
    s_cbranch_scc1 L_t16
    s_mov_b32 s38, 5
    s_mov_b32 s39, s29
    s_call_b64 s[40:41], L_poll
L_t16:
    ds_read_b128 v[12:15], v10 offset:128
    s_waitcnt lgkmcnt(0)
L_chk17:
    v_cmp_eq_u32 vcc, 0, v15
    s_cbranch_vccz L_rdy17
    s_sleep 1
    ds_read_b128 v[12:15], v10 offset:128
    s_waitcnt lgkmcnt(0)
    s_branch L_chk17
L_rdy17:
    v_cmp_eq_u32 vcc, 2, v15
    s_mov_b32 s38, 4
    s_cbranch_vccnz L_fallback
    v_dot2_f32_bf16 v16, v60, s34, v14
    v_dot2_f32_bf16 v17, v60, s35, v14
    v_dot2_f32_bf16 v18, v61, s34, v14
    v_dot2_f32_bf16 v19, v61, s35, v14
    v_dot2_f32_bf16 v20, v62, s34, v14
    v_dot2_f32_bf16 v21, v62, s35, v14
    v_dot2_f32_bf16 v22, v63, s34, v14
    v_dot2_f32_bf16 v23, v63, s35, v14
    v_pk_fma_f32 v[16:17], v[16:17], v[12:13], v[12:13] op_sel:[0,0,1] op_sel_hi:[1,0,1]
    v_pk_fma_f32 v[18:19], v[18:19], v[12:13], v[12:13] op_sel:[0,0,1] op_sel_hi:[1,0,1]
    v_pk_fma_f32 v[20:21], v[20:21], v[12:13], v[12:13] op_sel:[0,0,1] op_sel_hi:[1,0,1]
    v_pk_fma_f32 v[22:23], v[22:23], v[12:13], v[12:13] op_sel:[0,0,1] op_sel_hi:[1,0,1]
    v_cvt_pk_bf16_f32 v60, v16, v17
    v_cvt_pk_bf16_f32 v61, v18, v19
    v_cvt_pk_bf16_f32 v62, v20, v21
    v_cvt_pk_bf16_f32 v63, v22, v23
    v_dot2_f32_bf16 v16, v64, s34, v14
    v_dot2_f32_bf16 v17, v64, s35, v14
    v_dot2_f32_bf16 v18, v65, s34, v14
    v_dot2_f32_bf16 v19, v65, s35, v14
    v_dot2_f32_bf16 v20, v66, s34, v14
    v_dot2_f32_bf16 v21, v66, s35, v14
    v_dot2_f32_bf16 v22, v67, s34, v14
    v_dot2_f32_bf16 v23, v67, s35, v14
    v_pk_fma_f32 v[16:17], v[16:17], v[12:13], v[12:13] op_sel:[0,0,1] op_sel_hi:[1,0,1]
    v_pk_fma_f32 v[18:19], v[18:19], v[12:13], v[12:13] op_sel:[0,0,1] op_sel_hi:[1,0,1]
    v_pk_fma_f32 v[20:21], v[20:21], v[12:13], v[12:13] op_sel:[0,0,1] op_sel_hi:[1,0,1]
    v_pk_fma_f32 v[22:23], v[22:23], v[12:13], v[12:13] op_sel:[0,0,1] op_sel_hi:[1,0,1]
    v_cvt_pk_bf16_f32 v64, v16, v17
    v_cvt_pk_bf16_f32 v65, v18, v19
    v_cvt_pk_bf16_f32 v66, v20, v21
    v_cvt_pk_bf16_f32 v67, v22, v23
    ds_read_b128 v[12:15], v10 offset:144
    s_waitcnt lgkmcnt(0)
L_chk18:
    v_cmp_eq_u32 vcc, 0, v15
    s_cbranch_vccz L_rdy18
    s_sleep 1
    ds_read_b128 v[12:15], v10 offset:144
    s_waitcnt lgkmcnt(0)
    s_branch L_chk18
L_rdy18:
    v_cmp_eq_u32 vcc, 2, v15
    s_mov_b32 s38, 4
    s_cbranch_vccnz L_fallback
    v_dot2_f32_bf16 v16, v68, s34, v14
    v_dot2_f32_bf16 v17, v68, s35, v14
    v_dot2_f32_bf16 v18, v69, s34, v14
    v_dot2_f32_bf16 v19, v69, s35, v14
    v_dot2_f32_bf16 v20, v70, s34, v14
    v_dot2_f32_bf16 v21, v70, s35, v14
    v_dot2_f32_bf16 v22, v71, s34, v14
    v_dot2_f32_bf16 v23, v71, s35, v14
    v_pk_fma_f32 v[16:17], v[16:17], v[12:13], v[12:13] op_sel:[0,0,1] op_sel_hi:[1,0,1]
    v_pk_fma_f32 v[18:19], v[18:19], v[12:13], v[12:13] op_sel:[0,0,1] op_sel_hi:[1,0,1]
    v_pk_fma_f32 v[20:21], v[20:21], v[12:13], v[12:13] op_sel:[0,0,1] op_sel_hi:[1,0,1]
    v_pk_fma_f32 v[22:23], v[22:23], v[12:13], v[12:13] op_sel:[0,0,1] op_sel_hi:[1,0,1]
    v_cvt_pk_bf16_f32 v68, v16, v17
    v_cvt_pk_bf16_f32 v69, v18, v19
    v_cvt_pk_bf16_f32 v70, v20, v21
    v_cvt_pk_bf16_f32 v71, v22, v23
    v_dot2_f32_bf16 v16, v72, s34, v14
    v_dot2_f32_bf16 v17, v72, s35, v14
    v_dot2_f32_bf16 v18, v73, s34, v14
    v_dot2_f32_bf16 v19, v73, s35, v14
    v_dot2_f32_bf16 v20, v74, s34, v14
    v_dot2_f32_bf16 v21, v74, s35, v14
    v_dot2_f32_bf16 v22, v75, s34, v14
    v_dot2_f32_bf16 v23, v75, s35, v14
    v_pk_fma_f32 v[16:17], v[16:17], v[12:13], v[12:13] op_sel:[0,0,1] op_sel_hi:[1,0,1]
    v_pk_fma_f32 v[18:19], v[18:19], v[12:13], v[12:13] op_sel:[0,0,1] op_sel_hi:[1,0,1]
    v_pk_fma_f32 v[20:21], v[20:21], v[12:13], v[12:13] op_sel:[0,0,1] op_sel_hi:[1,0,1]
    v_pk_fma_f32 v[22:23], v[22:23], v[12:13], v[12:13] op_sel:[0,0,1] op_sel_hi:[1,0,1]
    v_cvt_pk_bf16_f32 v72, v16, v17
    v_cvt_pk_bf16_f32 v73, v18, v19
    v_cvt_pk_bf16_f32 v74, v20, v21
    v_cvt_pk_bf16_f32 v75, v22, v23
    s_waitcnt vmcnt(3)
    v_dot2c_f32_bf16 v4, s32, v76
    v_dot2c_f32_bf16 v5, v76, v76
    v_dot2c_f32_bf16 v4, s32, v77
    v_dot2c_f32_bf16 v5, v77, v77
    v_dot2c_f32_bf16 v4, s32, v78
    v_dot2c_f32_bf16 v5, v78, v78
    v_dot2c_f32_bf16 v4, s32, v79
    v_dot2c_f32_bf16 v5, v79, v79
    s_waitcnt vmcnt(2)
    v_dot2c_f32_bf16 v4, s32, v80
    v_dot2c_f32_bf16 v5, v80, v80
    v_dot2c_f32_bf16 v4, s32, v81
    v_dot2c_f32_bf16 v5, v81, v81
    v_dot2c_f32_bf16 v4, s32, v82
    v_dot2c_f32_bf16 v5, v82, v82
    v_dot2c_f32_bf16 v4, s32, v83
    v_dot2c_f32_bf16 v5, v83, v83
    s_nop 2
    v_mul_f32 v8, 0x3d800000, v4
    v_mov_b32_dpp v9, v4 row_newbcast:0 row_mask:0xf bank_mask:0xf
    v_fma_f32 v7, -v4, v8, v5
    v_add_f32_dpp v6, v4, v4 quad_perm:[1,0,3,2] row_mask:0xf bank_mask:0xf
    v_sub_f32 v24, v4, v9
    v_mul_f32 v8, 0x3d800000, v24
    v_add_f32_dpp v6, v6, v6 quad_perm:[2,3,0,1] row_mask:0xf bank_mask:0xf
    v_fmac_f32 v7, v24, v8
    v_mov_b32 v4, 0
    v_add_f32_dpp v6, v6, v6 row_half_mirror row_mask:0xf bank_mask:0xf
    v_add_f32_dpp v7, v7, v7 quad_perm:[1,0,3,2] row_mask:0xf bank_mask:0xf
    v_mov_b32 v5, 0
    v_add_f32_dpp v6, v6, v6 row_mirror row_mask:0xf bank_mask:0xf
    v_add_f32_dpp v7, v7, v7 quad_perm:[2,3,0,1] row_mask:0xf bank_mask:0xf
    v_mul_f32 v9, 0x41800000, v9
    v_sub_f32 v24, v6, v9
    v_add_f32_dpp v7, v7, v7 row_half_mirror row_mask:0xf bank_mask:0xf
    v_mul_f32 v8, 0x3b800000, v24
    s_nop 0
    v_add_f32_dpp v7, v7, v7 row_mirror row_mask:0xf bank_mask:0xf
    v_fma_f32 v7, -v24, v8, v7
    s_mov_b32 exec_lo, 0x00010001
    s_mov_b32 exec_hi, 0x00010001
    ds_write_b64 v2, v[6:7] offset:3328
    s_mov_b64 exec, -1
    s_waitcnt lgkmcnt(0)
    s_barrier
    s_cmp_lg_u32 s18, 0
    s_cbranch_scc1 L_t19
    s_mov_b32 s38, 6
    s_mov_b32 s39, s42
    s_call_b64 s[40:41], L_pub
L_t19:
    buffer_store_dwordx4 v[60:63], v1, s[8:11], s28 offen sc1
    buffer_store_dwordx4 v[64:67], v1, s[8:11], s28 offen offset:1024 sc1
    s_cmp_lg_u32 s18, 2
    s_cbranch_scc1 L_t20
    s_mov_b32 s38, 6
    s_mov_b32 s39, s30
    s_call_b64 s[40:41], L_poll
L_t20:
    buffer_store_dwordx4 v[68:71], v1, s[8:11], s29 offen sc1
    buffer_store_dwordx4 v[72:75], v1, s[8:11], s29 offen offset:1024 sc1
    v_lshlrev_b32 v28, 16, v76
    v_and_b32 v29, s33, v76
    v_lshlrev_b32 v30, 16, v77
    v_and_b32 v31, s33, v77
    v_lshlrev_b32 v32, 16, v78
    v_and_b32 v33, s33, v78
    v_lshlrev_b32 v34, 16, v79
    v_and_b32 v35, s33, v79
    v_lshlrev_b32 v36, 16, v80
    v_and_b32 v37, s33, v80
    v_lshlrev_b32 v38, 16, v81
    v_and_b32 v39, s33, v81
    v_lshlrev_b32 v40, 16, v82
    v_and_b32 v41, s33, v82
    v_lshlrev_b32 v42, 16, v83
    v_and_b32 v43, s33, v83
    ds_read_b128 v[12:15], v10 offset:160
    s_waitcnt lgkmcnt(0)
L_chk21:
    v_cmp_eq_u32 vcc, 0, v15
    s_cbranch_vccz L_rdy21
    s_sleep 1
    ds_read_b128 v[12:15], v10 offset:160
    s_waitcnt lgkmcnt(0)
    s_branch L_chk21
L_rdy21:
    v_cmp_eq_u32 vcc, 2, v15
    s_mov_b32 s38, 6
    s_cbranch_vccnz L_fallback
    v_pk_add_f32 v[28:29], v[28:29], v[14:15] op_sel_hi:[1,0]
    v_pk_add_f32 v[30:31], v[30:31], v[14:15] op_sel_hi:[1,0]
    v_pk_add_f32 v[32:33], v[32:33], v[14:15] op_sel_hi:[1,0]
    v_pk_add_f32 v[34:35], v[34:35], v[14:15] op_sel_hi:[1,0]
    v_pk_fma_f32 v[28:29], v[28:29], v[12:13], v[12:13] op_sel:[0,0,1] op_sel_hi:[1,0,1]
    v_pk_fma_f32 v[30:31], v[30:31], v[12:13], v[12:13] op_sel:[0,0,1] op_sel_hi:[1,0,1]
    v_pk_fma_f32 v[32:33], v[32:33], v[12:13], v[12:13] op_sel:[0,0,1] op_sel_hi:[1,0,1]
    v_pk_fma_f32 v[34:35], v[34:35], v[12:13], v[12:13] op_sel:[0,0,1] op_sel_hi:[1,0,1]
    v_cvt_pk_bf16_f32 v76, v28, v29
    v_cvt_pk_bf16_f32 v77, v30, v31
    v_cvt_pk_bf16_f32 v78, v32, v33
    v_cvt_pk_bf16_f32 v79, v34, v35
    buffer_store_dwordx4 v[76:79], v1, s[8:11], s30 offen sc1
    v_pk_add_f32 v[36:37], v[36:37], v[14:15] op_sel_hi:[1,0]
    v_pk_add_f32 v[38:39], v[38:39], v[14:15] op_sel_hi:[1,0]
    v_pk_add_f32 v[40:41], v[40:41], v[14:15] op_sel_hi:[1,0]
    v_pk_add_f32 v[42:43], v[42:43], v[14:15] op_sel_hi:[1,0]
    v_pk_fma_f32 v[36:37], v[36:37], v[12:13], v[12:13] op_sel:[0,0,1] op_sel_hi:[1,0,1]
    v_pk_fma_f32 v[38:39], v[38:39], v[12:13], v[12:13] op_sel:[0,0,1] op_sel_hi:[1,0,1]
    v_pk_fma_f32 v[40:41], v[40:41], v[12:13], v[12:13] op_sel:[0,0,1] op_sel_hi:[1,0,1]
    v_pk_fma_f32 v[42:43], v[42:43], v[12:13], v[12:13] op_sel:[0,0,1] op_sel_hi:[1,0,1]
    v_cvt_pk_bf16_f32 v80, v36, v37
    v_cvt_pk_bf16_f32 v81, v38, v39
    v_cvt_pk_bf16_f32 v82, v40, v41
    v_cvt_pk_bf16_f32 v83, v42, v43
    buffer_store_dwordx4 v[80:83], v1, s[8:11], s30 offen offset:1024 sc1
L_end:
    s_endpgm

L_pub:
    s_setprio 2
    s_lshl_b32 s3, s38, 9
    v_add_u32 v26, s3, v3
    ds_read_b64 v[6:7], v26 offset:256
    ds_read_b32 v24, v10 offset:32
    s_lshl_b32 s3, s38, 5
    s_add_u32 s3, s3, s39
    s_add_u32 s52, s3, s37
    s_add_u32 s53, s52, 0x100
    s_add_u32 s54, s52, 0x400
    s_add_u32 s55, s52, 0x500
    s_waitcnt lgkmcnt(0)
    s_cmp_lg_u32 s38, 0
    s_cbranch_scc1 L_pub_nosig
    v_readfirstlane_b32 s56, v24
    s_getreg_b32 s57, hwreg(HW_REG_XCC_ID, 2, 1)
    s_cmp_eq_u32 s57, 0
    s_cselect_b32 s3, 1, -1
    s_mul_i32 s56, s56, s3
    s_add_u32 s56, s56, 1
    s_addc_u32 s57, s57, 0
    s_atomic_add_x2 s[56:57], s[16:17], s52 offset:224
    s_atomic_add_x2 s[56:57], s[16:17], s53 offset:224
    s_atomic_add_x2 s[56:57], s[16:17], s54 offset:224
    s_atomic_add_x2 s[56:57], s[16:17], s55 offset:224
L_pub_nosig:
    v_readfirstlane_b32 s46, v6
    v_add_f32_dpp v8, v6, v6 quad_perm:[1,0,3,2] row_mask:0xf bank_mask:0xf
    s_nop 0
    v_subrev_f32 v6, s46, v6
    v_add_f32_dpp v8, v8, v8 quad_perm:[2,3,0,1] row_mask:0xf bank_mask:0xf
    v_mul_f32 v9, 0x3b800000, v6
    v_fmac_f32 v7, v6, v9
    v_add_f32_dpp v8, v8, v8 row_half_mirror row_mask:0xf bank_mask:0xf
    v_mov_b32 v9, s46
    v_add_f32_dpp v7, v7, v7 quad_perm:[1,0,3,2] row_mask:0xf bank_mask:0xf
    v_add_f32_dpp v8, v8, v8 row_mirror row_mask:0xf bank_mask:0xf
    s_nop 0
    v_add_f32_dpp v7, v7, v7 quad_perm:[2,3,0,1] row_mask:0xf bank_mask:0xf
    v_add_f32_dpp v8, v8, v8 row_bcast:15 row_mask:0xa bank_mask:0xf
    s_nop 0
    v_add_f32_dpp v7, v7, v7 row_half_mirror row_mask:0xf bank_mask:0xf
    v_add_f32_dpp v8, v8, v8 row_bcast:31 row_mask:0xc bank_mask:0xf
    s_nop 0
    v_add_f32_dpp v7, v7, v7 row_mirror row_mask:0xf bank_mask:0xf
    v_fmamk_f32 v6, v9, 0xc2800000, v8
    v_readlane_b32 s44, v8, 63
    v_add_f32_dpp v7, v7, v7 row_bcast:15 row_mask:0xa bank_mask:0xf
    v_mul_f32 v9, 0x38800000, v6
    s_nop 0
    v_add_f32_dpp v7, v7, v7 row_bcast:31 row_mask:0xc bank_mask:0xf
    v_fma_f32 v7, -v6, v9, v7
    s_nop 0
    v_readlane_b32 s45, v7, 63
    s_nop 3
    s_bitset0_b32 s45, 31
    s_add_u32 s44, s44, 1
    s_addc_u32 s45, s45, 0
    s_atomic_add_x2 s[44:45], s[16:17], s52
    s_atomic_add_x2 s[44:45], s[16:17], s53
    s_atomic_add_x2 s[44:45], s[16:17], s54
    s_atomic_add_x2 s[44:45], s[16:17], s55
    s_setprio 0
    s_setpc_b64 s[40:41]

L_poll:
    s_setprio 2
    s_lshr_b32 s54, s39, 17
    s_lshl_b32 s3, s54, 1
    s_and_b32 s3, s3, -4
    s_load_dword s52, s[12:13], s3
    s_load_dword s53, s[14:15], s3
    s_lshl_b32 s55, s38, 5
    s_add_u32 s55, s55, s36
    s_movk_i32 s56, 300
    v_mov_b32 v19, 2
    s_mov_b64 s[60:61], 0
    s_mov_b64 s[62:63], 0
    s_mov_b64 s[64:65], 0
    s_mov_b64 s[66:67], 0
L_poll_loop:
    s_load_dwordx8 s[44:51], s[16:17], s55 glc
    s_cmp_lg_u32 s38, 0
    s_cbranch_scc1 L_poll_nosig
    s_load_dwordx8 s[60:67], s[16:17], s55 offset:224 glc
L_poll_nosig:
    s_waitcnt lgkmcnt(0)
    s_or_b32 s3, s45, s47
    s_or_b32 s57, s49, s51
    s_or_b32 s3, s3, s57
    s_or_b32 s57, s61, s63
    s_or_b32 s3, s3, s57
    s_or_b32 s57, s65, s67
    s_or_b32 s3, s3, s57
    s_bitcmp1_b32 s3, 31
    s_cbranch_scc0 L_poll_ok
    s_sub_u32 s56, s56, 1
    s_cmp_lg_u32 s56, 0
    s_cbranch_scc1 L_poll_loop
    s_branch L_poll_out
L_poll_ok:
    v_mov_b32 v6, s44
    v_mov_b32 v7, s48
    v_add_f32 v6, s46, v6
    v_add_f32 v7, s50, v7
    v_mov_b32 v8, s45
    v_add_f32 v6, v6, v7
    v_add_f32 v8, s47, v8
    v_mul_f32 v6, 0xb7800000, v6
    v_add_f32 v8, s49, v8
    v_cvt_pk_bf16_f32 v18, 0, v6
    v_add_f32 v8, s51, v8
    v_mul_f32 v9, 0x46800000, v18
    v_add_f32 v6, s44, v9
    v_add_f32 v7, s46, v9
    v_add_f32 v24, s48, v9
    v_add_f32 v9, s50, v9
    v_mul_f32 v6, v6, v6
    v_mul_f32 v24, v24, v24
    v_fmac_f32 v6, v7, v7
    v_fmac_f32 v24, v9, v9
    s_add_i32 s60, s60, s62
    s_add_i32 s64, s64, s66
    s_add_i32 s60, s60, s64
    v_add_f32 v6, v6, v24
    s_cmp_eq_u32 s20, 0
    s_cselect_b32 s61, s61, s65
    v_fmac_f32 v8, 0x38800000, v6
    s_cmp_lt_i32 s60, 0
    s_cselect_b32 s60, 1, 0
    v_mul_f32 v8, 0x37800000, v8
    s_xor_b32 s60, s60, s61
    s_xor_b32 s60, s60, s21
    s_lshl2_add_u32 s60, s60, 1
    v_cvt_pk_bf16_f32 v8, 0, v8
    s_bitcmp1_b32 s54, 0
    v_add_f32 v8, 0x3727c5ac, v8
    s_cselect_b32 s3, 0, 16
    v_cvt_pk_bf16_f32 v8, 0, v8
    s_lshl_b32 s52, s52, s3
    v_sqrt_f32 v8, v8
    s_and_b32 s52, s52, s33
    v_cvt_pk_bf16_f32 v8, 0, v8
    s_lshl_b32 s53, s53, s3
    v_rcp_f32 v9, v8
    s_and_b32 s53, s53, s33
    v_mov_b32 v17, s53
    v_mul_f32 v16, s52, v9
    v_mov_b32 v19, s60
L_poll_out:
    s_lshl_b32 s3, s38, 4
    v_mov_b32 v6, s3
    s_mov_b64 exec, 1
    ds_write_b128 v6, v[16:19] offset:64
    s_mov_b64 exec, -1
    s_setprio 0
    s_setpc_b64 s[40:41]

L_fallback:
    s_waitcnt vmcnt(0) lgkmcnt(0)
    s_lshl_b32 s64, s18, 13
    s_lshr_b32 s65, s18, 3
    v_mov_b32 v4, 0
    v_mov_b32 v5, 0
L_fb_loop:
    s_sub_u32 s3, s38, 3
    s_max_i32 s3, s3, 0
    s_add_u32 s3, s3, s68
    s_and_b32 s3, s3, 3
    s_lshl2_add_u32 s54, s19, s3
    s_lshl_b32 s3, s38, 6
    s_add_u32 s3, s3, s19
    s_add_u32 s3, s3, 192
    s_sub_u32 s52, s38, 1
    s_cmp_lt_u32 s52, 3
    s_cselect_b32 s54, s3, s54
    s_lshl_b32 s3, s54, 1
    s_and_b32 s3, s3, -4
    s_load_dword s52, s[12:13], s3
    s_load_dword s53, s[14:15], s3
    s_lshl_b32 s56, s54, 17
    s_add_u32 s56, s56, s64
    s_add_u32 s57, s56, 0x1000
    buffer_load_dwordx4 v[28:31], v1, s[4:7], s56 offen offset:0
    buffer_load_dwordx4 v[32:35], v1, s[4:7], s56 offen offset:1024
    buffer_load_dwordx4 v[36:39], v1, s[4:7], s56 offen offset:2048
    buffer_load_dwordx4 v[40:43], v1, s[4:7], s56 offen offset:3072
    buffer_load_dwordx4 v[44:47], v1, s[4:7], s57 offen offset:0
    buffer_load_dwordx4 v[48:51], v1, s[4:7], s57 offen offset:1024
    buffer_load_dwordx4 v[52:55], v1, s[4:7], s57 offen offset:2048
    buffer_load_dwordx4 v[56:59], v1, s[4:7], s57 offen offset:3072
    s_waitcnt vmcnt(0)
    s_barrier
    v_dot2c_f32_bf16 v4, s32, v28
    v_dot2c_f32_bf16 v5, v28, v28
    v_dot2c_f32_bf16 v4, s32, v29
    v_dot2c_f32_bf16 v5, v29, v29
    v_dot2c_f32_bf16 v4, s32, v30
    v_dot2c_f32_bf16 v5, v30, v30
    v_dot2c_f32_bf16 v4, s32, v31
    v_dot2c_f32_bf16 v5, v31, v31
    v_dot2c_f32_bf16 v4, s32, v32
    v_dot2c_f32_bf16 v5, v32, v32
    v_dot2c_f32_bf16 v4, s32, v33
    v_dot2c_f32_bf16 v5, v33, v33
    v_dot2c_f32_bf16 v4, s32, v34
    v_dot2c_f32_bf16 v5, v34, v34
    v_dot2c_f32_bf16 v4, s32, v35
    v_dot2c_f32_bf16 v5, v35, v35
    v_dot2c_f32_bf16 v4, s32, v36
    v_dot2c_f32_bf16 v5, v36, v36
    v_dot2c_f32_bf16 v4, s32, v37
    v_dot2c_f32_bf16 v5, v37, v37
    v_dot2c_f32_bf16 v4, s32, v38
    v_dot2c_f32_bf16 v5, v38, v38
    v_dot2c_f32_bf16 v4, s32, v39
    v_dot2c_f32_bf16 v5, v39, v39
    v_dot2c_f32_bf16 v4, s32, v40
    v_dot2c_f32_bf16 v5, v40, v40
    v_dot2c_f32_bf16 v4, s32, v41
    v_dot2c_f32_bf16 v5, v41, v41
    v_dot2c_f32_bf16 v4, s32, v42
    v_dot2c_f32_bf16 v5, v42, v42
    v_dot2c_f32_bf16 v4, s32, v43
    v_dot2c_f32_bf16 v5, v43, v43
    v_dot2c_f32_bf16 v4, s32, v44
    v_dot2c_f32_bf16 v5, v44, v44
    v_dot2c_f32_bf16 v4, s32, v45
    v_dot2c_f32_bf16 v5, v45, v45
    v_dot2c_f32_bf16 v4, s32, v46
    v_dot2c_f32_bf16 v5, v46, v46
    v_dot2c_f32_bf16 v4, s32, v47
    v_dot2c_f32_bf16 v5, v47, v47
    v_dot2c_f32_bf16 v4, s32, v48
    v_dot2c_f32_bf16 v5, v48, v48
    v_dot2c_f32_bf16 v4, s32, v49
    v_dot2c_f32_bf16 v5, v49, v49
    v_dot2c_f32_bf16 v4, s32, v50
    v_dot2c_f32_bf16 v5, v50, v50
    v_dot2c_f32_bf16 v4, s32, v51
    v_dot2c_f32_bf16 v5, v51, v51
    v_dot2c_f32_bf16 v4, s32, v52
    v_dot2c_f32_bf16 v5, v52, v52
    v_dot2c_f32_bf16 v4, s32, v53
    v_dot2c_f32_bf16 v5, v53, v53
    v_dot2c_f32_bf16 v4, s32, v54
    v_dot2c_f32_bf16 v5, v54, v54
    v_dot2c_f32_bf16 v4, s32, v55
    v_dot2c_f32_bf16 v5, v55, v55
    v_dot2c_f32_bf16 v4, s32, v56
    v_dot2c_f32_bf16 v5, v56, v56
    v_dot2c_f32_bf16 v4, s32, v57
    v_dot2c_f32_bf16 v5, v57, v57
    v_dot2c_f32_bf16 v4, s32, v58
    v_dot2c_f32_bf16 v5, v58, v58
    v_dot2c_f32_bf16 v4, s32, v59
    v_dot2c_f32_bf16 v5, v59, v59
    s_nop 2
    v_mul_f32 v8, 0x3c800000, v4
    v_mov_b32_dpp v9, v4 row_newbcast:0 row_mask:0xf bank_mask:0xf
    v_fma_f32 v7, -v4, v8, v5
    v_add_f32_dpp v6, v4, v4 quad_perm:[1,0,3,2] row_mask:0xf bank_mask:0xf
    v_sub_f32 v24, v4, v9
    v_mul_f32 v8, 0x3c800000, v24
    v_add_f32_dpp v6, v6, v6 quad_perm:[2,3,0,1] row_mask:0xf bank_mask:0xf
    v_fmac_f32 v7, v24, v8
    v_mov_b32 v4, 0
    v_add_f32_dpp v6, v6, v6 row_half_mirror row_mask:0xf bank_mask:0xf
    v_add_f32_dpp v7, v7, v7 quad_perm:[1,0,3,2] row_mask:0xf bank_mask:0xf
    v_mov_b32 v5, 0
    v_add_f32_dpp v6, v6, v6 row_mirror row_mask:0xf bank_mask:0xf
    v_add_f32_dpp v7, v7, v7 quad_perm:[2,3,0,1] row_mask:0xf bank_mask:0xf
    v_mul_f32 v9, 0x41800000, v9
    v_sub_f32 v24, v6, v9
    v_add_f32_dpp v7, v7, v7 row_half_mirror row_mask:0xf bank_mask:0xf
    v_mul_f32 v8, 0x3a800000, v24
    s_nop 0
    v_add_f32_dpp v7, v7, v7 row_mirror row_mask:0xf bank_mask:0xf
    v_fma_f32 v7, -v24, v8, v7
    s_mov_b32 exec_lo, 0x00010001
    s_mov_b32 exec_hi, 0x00010001
    ds_write_b64 v2, v[6:7] offset:256
    s_mov_b64 exec, -1
    s_waitcnt lgkmcnt(0)
    s_barrier
    ds_read_b64 v[6:7], v3 offset:256
    s_waitcnt lgkmcnt(0)
    v_mov_b32 v8, v6
    s_nop 1
    v_add_f32_dpp v8, v8, v8 quad_perm:[1,0,3,2] row_mask:0xf bank_mask:0xf
    s_nop 1
    v_add_f32_dpp v8, v8, v8 quad_perm:[2,3,0,1] row_mask:0xf bank_mask:0xf
    s_nop 1
    v_add_f32_dpp v8, v8, v8 row_half_mirror row_mask:0xf bank_mask:0xf
    s_nop 1
    v_add_f32_dpp v8, v8, v8 row_mirror row_mask:0xf bank_mask:0xf
    s_nop 1
    v_add_f32_dpp v8, v8, v8 row_bcast:15 row_mask:0xa bank_mask:0xf
    s_nop 1
    v_add_f32_dpp v8, v8, v8 row_bcast:31 row_mask:0xc bank_mask:0xf
    s_nop 0
    v_readlane_b32 s44, v8, 63
    s_nop 1
    v_mov_b32 v9, s44
    v_mul_f32 v9, 0xb7800000, v9
    v_cvt_pk_bf16_f32 v14, 0, v9
    v_fmac_f32 v6, 0x44800000, v14
    v_mul_f32 v9, 0x3a800000, v6
    v_fmac_f32 v7, v6, v9
    s_nop 1
    v_add_f32_dpp v7, v7, v7 quad_perm:[1,0,3,2] row_mask:0xf bank_mask:0xf
    s_nop 1
    v_add_f32_dpp v7, v7, v7 quad_perm:[2,3,0,1] row_mask:0xf bank_mask:0xf
    s_nop 1
    v_add_f32_dpp v7, v7, v7 row_half_mirror row_mask:0xf bank_mask:0xf
    s_nop 1
    v_add_f32_dpp v7, v7, v7 row_mirror row_mask:0xf bank_mask:0xf
    s_nop 1
    v_add_f32_dpp v7, v7, v7 row_bcast:15 row_mask:0xa bank_mask:0xf
    s_nop 1
    v_add_f32_dpp v7, v7, v7 row_bcast:31 row_mask:0xc bank_mask:0xf
    s_nop 0
    v_readlane_b32 s45, v7, 63
    s_nop 1
    v_mov_b32 v8, s45
    v_mul_f32 v8, 0x37800000, v8
    v_cvt_pk_bf16_f32 v8, 0, abs(v8)
    s_bitcmp1_b32 s54, 0
    v_add_f32 v8, 0x3727c5ac, v8
    s_cselect_b32 s3, 0, 16
    v_cvt_pk_bf16_f32 v8, 0, v8
    s_lshl_b32 s52, s52, s3
    v_sqrt_f32 v8, v8
    s_and_b32 s52, s52, s33
    v_cvt_pk_bf16_f32 v8, 0, v8
    s_lshl_b32 s53, s53, s3
    v_rcp_f32 v9, v8
    s_and_b32 s53, s53, s33
    v_mov_b32 v13, s53
    v_mul_f32 v12, s52, v9
    s_cmp_lg_u32 s65, s20
    s_cbranch_scc1 L_fb_next
    v_dot2_f32_bf16 v16, v28, s34, v14
    v_dot2_f32_bf16 v17, v28, s35, v14
    v_dot2_f32_bf16 v18, v29, s34, v14
    v_dot2_f32_bf16 v19, v29, s35, v14
    v_dot2_f32_bf16 v20, v30, s34, v14
    v_dot2_f32_bf16 v21, v30, s35, v14
    v_dot2_f32_bf16 v22, v31, s34, v14
    v_dot2_f32_bf16 v23, v31, s35, v14
    v_pk_fma_f32 v[16:17], v[16:17], v[12:13], v[12:13] op_sel:[0,0,1] op_sel_hi:[1,0,1]
    v_pk_fma_f32 v[18:19], v[18:19], v[12:13], v[12:13] op_sel:[0,0,1] op_sel_hi:[1,0,1]
    v_pk_fma_f32 v[20:21], v[20:21], v[12:13], v[12:13] op_sel:[0,0,1] op_sel_hi:[1,0,1]
    v_pk_fma_f32 v[22:23], v[22:23], v[12:13], v[12:13] op_sel:[0,0,1] op_sel_hi:[1,0,1]
    v_cvt_pk_bf16_f32 v28, v16, v17
    v_cvt_pk_bf16_f32 v29, v18, v19
    v_cvt_pk_bf16_f32 v30, v20, v21
    v_cvt_pk_bf16_f32 v31, v22, v23
    buffer_store_dwordx4 v[28:31], v1, s[8:11], s56 offen offset:0
    v_dot2_f32_bf16 v16, v32, s34, v14
    v_dot2_f32_bf16 v17, v32, s35, v14
    v_dot2_f32_bf16 v18, v33, s34, v14
    v_dot2_f32_bf16 v19, v33, s35, v14
    v_dot2_f32_bf16 v20, v34, s34, v14
    v_dot2_f32_bf16 v21, v34, s35, v14
    v_dot2_f32_bf16 v22, v35, s34, v14
    v_dot2_f32_bf16 v23, v35, s35, v14
    v_pk_fma_f32 v[16:17], v[16:17], v[12:13], v[12:13] op_sel:[0,0,1] op_sel_hi:[1,0,1]
    v_pk_fma_f32 v[18:19], v[18:19], v[12:13], v[12:13] op_sel:[0,0,1] op_sel_hi:[1,0,1]
    v_pk_fma_f32 v[20:21], v[20:21], v[12:13], v[12:13] op_sel:[0,0,1] op_sel_hi:[1,0,1]
    v_pk_fma_f32 v[22:23], v[22:23], v[12:13], v[12:13] op_sel:[0,0,1] op_sel_hi:[1,0,1]
    v_cvt_pk_bf16_f32 v32, v16, v17
    v_cvt_pk_bf16_f32 v33, v18, v19
    v_cvt_pk_bf16_f32 v34, v20, v21
    v_cvt_pk_bf16_f32 v35, v22, v23
    buffer_store_dwordx4 v[32:35], v1, s[8:11], s56 offen offset:1024
    v_dot2_f32_bf16 v16, v36, s34, v14
    v_dot2_f32_bf16 v17, v36, s35, v14
    v_dot2_f32_bf16 v18, v37, s34, v14
    v_dot2_f32_bf16 v19, v37, s35, v14
    v_dot2_f32_bf16 v20, v38, s34, v14
    v_dot2_f32_bf16 v21, v38, s35, v14
    v_dot2_f32_bf16 v22, v39, s34, v14
    v_dot2_f32_bf16 v23, v39, s35, v14
    v_pk_fma_f32 v[16:17], v[16:17], v[12:13], v[12:13] op_sel:[0,0,1] op_sel_hi:[1,0,1]
    v_pk_fma_f32 v[18:19], v[18:19], v[12:13], v[12:13] op_sel:[0,0,1] op_sel_hi:[1,0,1]
    v_pk_fma_f32 v[20:21], v[20:21], v[12:13], v[12:13] op_sel:[0,0,1] op_sel_hi:[1,0,1]
    v_pk_fma_f32 v[22:23], v[22:23], v[12:13], v[12:13] op_sel:[0,0,1] op_sel_hi:[1,0,1]
    v_cvt_pk_bf16_f32 v36, v16, v17
    v_cvt_pk_bf16_f32 v37, v18, v19
    v_cvt_pk_bf16_f32 v38, v20, v21
    v_cvt_pk_bf16_f32 v39, v22, v23
    buffer_store_dwordx4 v[36:39], v1, s[8:11], s56 offen offset:2048
    v_dot2_f32_bf16 v16, v40, s34, v14
    v_dot2_f32_bf16 v17, v40, s35, v14
    v_dot2_f32_bf16 v18, v41, s34, v14
    v_dot2_f32_bf16 v19, v41, s35, v14
    v_dot2_f32_bf16 v20, v42, s34, v14
    v_dot2_f32_bf16 v21, v42, s35, v14
    v_dot2_f32_bf16 v22, v43, s34, v14
    v_dot2_f32_bf16 v23, v43, s35, v14
    v_pk_fma_f32 v[16:17], v[16:17], v[12:13], v[12:13] op_sel:[0,0,1] op_sel_hi:[1,0,1]
    v_pk_fma_f32 v[18:19], v[18:19], v[12:13], v[12:13] op_sel:[0,0,1] op_sel_hi:[1,0,1]
    v_pk_fma_f32 v[20:21], v[20:21], v[12:13], v[12:13] op_sel:[0,0,1] op_sel_hi:[1,0,1]
    v_pk_fma_f32 v[22:23], v[22:23], v[12:13], v[12:13] op_sel:[0,0,1] op_sel_hi:[1,0,1]
    v_cvt_pk_bf16_f32 v40, v16, v17
    v_cvt_pk_bf16_f32 v41, v18, v19
    v_cvt_pk_bf16_f32 v42, v20, v21
    v_cvt_pk_bf16_f32 v43, v22, v23
    buffer_store_dwordx4 v[40:43], v1, s[8:11], s56 offen offset:3072
    v_dot2_f32_bf16 v16, v44, s34, v14
    v_dot2_f32_bf16 v17, v44, s35, v14
    v_dot2_f32_bf16 v18, v45, s34, v14
    v_dot2_f32_bf16 v19, v45, s35, v14
    v_dot2_f32_bf16 v20, v46, s34, v14
    v_dot2_f32_bf16 v21, v46, s35, v14
    v_dot2_f32_bf16 v22, v47, s34, v14
    v_dot2_f32_bf16 v23, v47, s35, v14
    v_pk_fma_f32 v[16:17], v[16:17], v[12:13], v[12:13] op_sel:[0,0,1] op_sel_hi:[1,0,1]
    v_pk_fma_f32 v[18:19], v[18:19], v[12:13], v[12:13] op_sel:[0,0,1] op_sel_hi:[1,0,1]
    v_pk_fma_f32 v[20:21], v[20:21], v[12:13], v[12:13] op_sel:[0,0,1] op_sel_hi:[1,0,1]
    v_pk_fma_f32 v[22:23], v[22:23], v[12:13], v[12:13] op_sel:[0,0,1] op_sel_hi:[1,0,1]
    v_cvt_pk_bf16_f32 v44, v16, v17
    v_cvt_pk_bf16_f32 v45, v18, v19
    v_cvt_pk_bf16_f32 v46, v20, v21
    v_cvt_pk_bf16_f32 v47, v22, v23
    buffer_store_dwordx4 v[44:47], v1, s[8:11], s57 offen offset:0
    v_dot2_f32_bf16 v16, v48, s34, v14
    v_dot2_f32_bf16 v17, v48, s35, v14
    v_dot2_f32_bf16 v18, v49, s34, v14
    v_dot2_f32_bf16 v19, v49, s35, v14
    v_dot2_f32_bf16 v20, v50, s34, v14
    v_dot2_f32_bf16 v21, v50, s35, v14
    v_dot2_f32_bf16 v22, v51, s34, v14
    v_dot2_f32_bf16 v23, v51, s35, v14
    v_pk_fma_f32 v[16:17], v[16:17], v[12:13], v[12:13] op_sel:[0,0,1] op_sel_hi:[1,0,1]
    v_pk_fma_f32 v[18:19], v[18:19], v[12:13], v[12:13] op_sel:[0,0,1] op_sel_hi:[1,0,1]
    v_pk_fma_f32 v[20:21], v[20:21], v[12:13], v[12:13] op_sel:[0,0,1] op_sel_hi:[1,0,1]
    v_pk_fma_f32 v[22:23], v[22:23], v[12:13], v[12:13] op_sel:[0,0,1] op_sel_hi:[1,0,1]
    v_cvt_pk_bf16_f32 v48, v16, v17
    v_cvt_pk_bf16_f32 v49, v18, v19
    v_cvt_pk_bf16_f32 v50, v20, v21
    v_cvt_pk_bf16_f32 v51, v22, v23
    buffer_store_dwordx4 v[48:51], v1, s[8:11], s57 offen offset:1024
    v_dot2_f32_bf16 v16, v52, s34, v14
    v_dot2_f32_bf16 v17, v52, s35, v14
    v_dot2_f32_bf16 v18, v53, s34, v14
    v_dot2_f32_bf16 v19, v53, s35, v14
    v_dot2_f32_bf16 v20, v54, s34, v14
    v_dot2_f32_bf16 v21, v54, s35, v14
    v_dot2_f32_bf16 v22, v55, s34, v14
    v_dot2_f32_bf16 v23, v55, s35, v14
    v_pk_fma_f32 v[16:17], v[16:17], v[12:13], v[12:13] op_sel:[0,0,1] op_sel_hi:[1,0,1]
    v_pk_fma_f32 v[18:19], v[18:19], v[12:13], v[12:13] op_sel:[0,0,1] op_sel_hi:[1,0,1]
    v_pk_fma_f32 v[20:21], v[20:21], v[12:13], v[12:13] op_sel:[0,0,1] op_sel_hi:[1,0,1]
    v_pk_fma_f32 v[22:23], v[22:23], v[12:13], v[12:13] op_sel:[0,0,1] op_sel_hi:[1,0,1]
    v_cvt_pk_bf16_f32 v52, v16, v17
    v_cvt_pk_bf16_f32 v53, v18, v19
    v_cvt_pk_bf16_f32 v54, v20, v21
    v_cvt_pk_bf16_f32 v55, v22, v23
    buffer_store_dwordx4 v[52:55], v1, s[8:11], s57 offen offset:2048
    v_dot2_f32_bf16 v16, v56, s34, v14
    v_dot2_f32_bf16 v17, v56, s35, v14
    v_dot2_f32_bf16 v18, v57, s34, v14
    v_dot2_f32_bf16 v19, v57, s35, v14
    v_dot2_f32_bf16 v20, v58, s34, v14
    v_dot2_f32_bf16 v21, v58, s35, v14
    v_dot2_f32_bf16 v22, v59, s34, v14
    v_dot2_f32_bf16 v23, v59, s35, v14
    v_pk_fma_f32 v[16:17], v[16:17], v[12:13], v[12:13] op_sel:[0,0,1] op_sel_hi:[1,0,1]
    v_pk_fma_f32 v[18:19], v[18:19], v[12:13], v[12:13] op_sel:[0,0,1] op_sel_hi:[1,0,1]
    v_pk_fma_f32 v[20:21], v[20:21], v[12:13], v[12:13] op_sel:[0,0,1] op_sel_hi:[1,0,1]
    v_pk_fma_f32 v[22:23], v[22:23], v[12:13], v[12:13] op_sel:[0,0,1] op_sel_hi:[1,0,1]
    v_cvt_pk_bf16_f32 v56, v16, v17
    v_cvt_pk_bf16_f32 v57, v18, v19
    v_cvt_pk_bf16_f32 v58, v20, v21
    v_cvt_pk_bf16_f32 v59, v22, v23
    buffer_store_dwordx4 v[56:59], v1, s[8:11], s57 offen offset:3072
    s_waitcnt vmcnt(0)
L_fb_next:
    s_add_u32 s38, s38, 1
    s_cmp_lt_u32 s38, 7
    s_cbranch_scc1 L_fb_loop
    s_endpgm
.section .rodata,"a"
.p2align 6
.amdhsa_kernel standalone__instancenorm__prompt_kernel
  .amdhsa_next_free_vgpr 84
  .amdhsa_next_free_sgpr 72
  .amdhsa_accum_offset 84
  .amdhsa_group_segment_fixed_size 0
  .amdhsa_kernarg_size 48
  .amdhsa_user_sgpr_count 2
  .amdhsa_user_sgpr_kernarg_segment_ptr 1
  .amdhsa_system_sgpr_workgroup_id_x 1
  .amdhsa_float_denorm_mode_32 3
.end_amdhsa_kernel
```
